```python
import torch

def _softmax(x, axis=-1):
    return torch.softmax(x, dim=axis)
def _gelu(x):
    return torch.nn.functional.gelu(x, approximate="tanh")
def _silu(x):
    return torch.nn.functional.silu(x)
def _sigmoid(x):
    return torch.sigmoid(x)
def _layernorm(x, axis=-1, eps=1e-5):
    m = x.mean(dim=axis, keepdim=True)
    v = x.var(dim=axis, keepdim=True, unbiased=False)
    return (x - m) / torch.sqrt(v + eps)
def _scatter_add(tgt, idx, src, axis=0):
    return tgt.clone().index_add_(axis, idx, src)
def _segment_sum(src, seg, n):
    out = torch.zeros((n,) + src.shape[1:], dtype=src.dtype)
    return out.index_add_(0, seg, src)
def _pad(x, pw):
    flat = tuple(v for pair in reversed(pw) for v in pair)
    return torch.nn.functional.pad(x, flat)

kernel_name = 'recurrent_scan__sliding_block_cached__dense_activation_squared_relu__decode'

def setup_inputs():

    _w = (lambda a: (lambda t: t.to(torch.bfloat16) if t.is_floating_point() else t)(torch.as_tensor(a)))
    def _A_setup():
        B, Sq, D = 4, 1, 512
        Hq, Hkv, Sk, Dh = 32, 8, 4096, 128
        assert Hq % Hkv == 0, (Hq, Hkv)
        return {
            "x": _w((lambda *s: torch.randn(*s, dtype=torch.bfloat16) * 0.05)(B, Sq, D)),
            "k_cache": _w((lambda *s: torch.randn(*s, dtype=torch.bfloat16) * 0.8)(B, Hkv, Sk, Dh)),
            "v_cache": _w((lambda *s: torch.randn(*s, dtype=torch.bfloat16) * 0.2)(B, Hkv, Sk, Dh)),
            "wq": _w((lambda *s: torch.randn(*s, dtype=torch.bfloat16) * 0.8)(D, Hq * Dh) * (D ** -0.5)),
            "wo": _w((lambda *s: torch.randn(*s, dtype=torch.bfloat16) * 0.2)(Hq * Dh, D) * ((Hq * Dh) ** -0.5)),
        }
    _A_in = _A_setup()

    def _B_setup():
        B, S, D, F = 4, 1, 512, 1792
        return {
            "x": _w((lambda *s: torch.randn(*s, dtype=torch.bfloat16) * 0.05)(B, S, D)),
            "w1": _w((lambda *s: torch.randn(*s, dtype=torch.bfloat16) * 0.1)(D, F)),
            "b1": _w((lambda *s: torch.randn(*s, dtype=torch.bfloat16) * 0.4)(F)),
            "w2": _w((lambda *s: torch.randn(*s, dtype=torch.bfloat16) * 0.1)(F, D)),
            "b2": _w((lambda *s: torch.randn(*s, dtype=torch.bfloat16) * 6.4)(D)),
        }
    _B_in = _B_setup()

    return {
        "A_x": _A_in["x"],
        "A_k_cache": _A_in["k_cache"],
        "A_v_cache": _A_in["v_cache"],
        "A_wq": _A_in["wq"],
        "A_wo": _A_in["wo"],
        "B_x": _B_in["x"],
        "B_w1": _B_in["w1"],
        "B_b1": _B_in["b1"],
        "B_w2": _B_in["w2"],
        "B_b2": _B_in["b2"],
    }

def reference(A_x, A_k_cache, A_v_cache, A_wq, A_wo, B_x, B_w1, B_b1, B_w2, B_b2):
    def _A_ref(x, k_cache, v_cache, wq, wo):
        B, Sq, D = x.shape
        Hq, Dh = 32, 128
        Hkv, Sk = k_cache.shape[1], k_cache.shape[2]
        W = min(4096, max(256, Sk // 4))
        rep = Hq // Hkv
        q = (lambda x, *d: x.permute(*d))((x @ wq).reshape(B, Sq, Hq, Dh), 0, 2, 1, 3)
        k = (lambda x, n, axis: torch.repeat_interleave(x, n, dim=axis))(k_cache[:, :, Sk - W:, :], rep, axis=1)
        v = (lambda x, n, axis: torch.repeat_interleave(x, n, dim=axis))(v_cache[:, :, Sk - W:, :], rep, axis=1)
        scores = torch.einsum("bhqd,bhkd->bhqk", q, k) * (Dh ** -0.5)
        p = _softmax(scores, axis=-1)
        o = torch.einsum("bhqk,bhkd->bhqd", p, v)
        return (lambda x, *d: x.permute(*d))(o, 0, 2, 1, 3).reshape(B, Sq, Hq * Dh) @ wo

    def _B_ref(x, w1, b1, w2, b2):
        h = torch.einsum("bsd,df->bsf", x, w1) + b1
        zero = torch.zeros_like(h)
        r = torch.where(h > zero, h, zero)
        h = r * r
        out = torch.einsum("bsf,fd->bsd", h, w2) + b2
        return out

    x = A_x
    xn = _layernorm(x, axis=-1)
    s = _A_ref(xn, A_k_cache, A_v_cache, A_wq, A_wo)
    g = _silu(_B_ref(xn, B_w1, B_b1, B_w2, B_b2))
    return x + s * g
```

```asm
; @launch grid=(256,1,1) block=(1024,1,1) lds=129152
.amdgcn_target "amdgcn-amd-amdhsa--gfx950"
.text
.globl recurrent_scan__sliding_block_cached__dense_activation_squared_relu__decode_kernel
.p2align 8
.type recurrent_scan__sliding_block_cached__dense_activation_squared_relu__decode_kernel,@function
recurrent_scan__sliding_block_cached__dense_activation_squared_relu__decode_kernel:
    s_load_dwordx2 s[36:37], s[0:1], 24
    s_load_dwordx16 s[4:19], s[0:1], 0
    s_load_dwordx2 s[32:33], s[0:1], 96
    v_lshrrev_b32 v1, 6, v0
    s_cmpk_ge_u32 s2, 0x100
    s_cbranch_scc1 L_bail
    v_readfirstlane_b32 s3, v1
    v_and_b32 v0, 63, v0
    s_and_b32 s30, s2, 7
    s_cmp_ge_u32 s3, 12
    s_cbranch_scc1 L_disp
    s_cmp_ge_u32 s3, 4
    s_cbranch_scc1 L_cw
L_ld1:
    v_lshrrev_b32 v1, 3, v0
    v_and_b32 v2, 7, v0
    v_and_b32 v3, 2, v1
    s_and_b32 s43, s3, 1
    s_lshl_b32 s43, s43, 2
    v_or_b32 v3, s43, v3
    v_xor_b32 v2, v2, v3
    v_lshlrev_b32 v2, 4, v2
    v_lshl_add_u32 v4, v1, 13, v2
    s_lshr_b32 s50, s2, 6
    s_lshl_b32 s50, s50, 20
    s_and_b32 s45, s2, 56
    s_lshl4_add_u32 s50, s45, s50
    s_lshl_b32 s45, s30, 10
    s_add_u32 s50, s50, s45
    s_lshl_b32 s45, s3, 16
    s_add_u32 s50, s50, s45
    s_lshl_b32 s51, 1, 18
    s_lshl_b32 s44, s3, 10
    s_add_u32 m0, s44, 125056
    v_lshl_add_u32 v9, v0, 4, s44
    s_lshl_b32 s38, 1, 22
    s_lshl_b32 s39, 1, 17
    s_waitcnt lgkmcnt(0)
    global_load_lds_dwordx4 v9, s[4:5]
    s_mov_b32 m0, s44
    s_nop 0
    buffer_load_dwordx4 v4, s[36:39], s50 offen nt lds
    s_addk_i32 m0, 0x1000
    s_add_u32 s50, s50, s51
    buffer_load_dwordx4 v4, s[36:39], s50 offen nt lds
    s_addk_i32 m0, 0x1000
    s_add_u32 s50, s50, s51
    buffer_load_dwordx4 v4, s[36:39], s50 offen nt lds
    s_addk_i32 m0, 0x1000
    s_add_u32 s50, s50, s51
    buffer_load_dwordx4 v4, s[36:39], s50 offen nt lds
    s_addk_i32 m0, 0x1000
    s_branch L_ld2
L_disp:
    s_barrier
    s_mov_b64 exec, 0
    s_cmp_eq_u32 s3, 12
    s_cbranch_scc1 L_pad0
    s_cmp_eq_u32 s3, 13
    s_cbranch_scc1 L_pad1
    s_cmp_eq_u32 s3, 14
    s_cbranch_scc1 L_pad2
    s_branch L_pad3
L_mid:
    s_cmp_eq_u32 s3, 12
    s_cbranch_scc1 L_pad4
    s_cmp_eq_u32 s3, 13
    s_cbranch_scc1 L_pad5
    s_cmp_eq_u32 s3, 14
    s_cbranch_scc1 L_pad6
    s_branch L_pad7
L_bail:
    s_endpgm
L_ld2:
    s_barrier
    s_setprio 3
    s_lshr_b32 s31, s2, 3
    s_movk_i32 s43, 3584
    v_mul_u32_u24 v5, s43, v1
    v_add_u32 v5, v5, v2
    s_load_dwordx2 s[20:21], s[0:1], 64
    s_add_u32 s49, s31, 4
    s_lshr_b32 s49, s49, 3
    s_sub_u32 s49, s31, s49
    s_mul_i32 s44, s30, 229376
    s_lshl_b32 s46, s49, 7
    s_add_u32 s44, s44, s46
    s_mul_i32 s46, s3, 28672
    s_add_u32 s52, s44, s46
    s_and_b32 s44, s31, 7
    s_cmp_lg_u32 s44, 3
    s_cselect_b32 s57, 1835008, 0
    s_mov_b32 s58, 114688
    s_mov_b32 s36, s16
    s_mov_b32 s37, s17
    s_mov_b32 s38, s57
    buffer_load_dwordx4 v5, s[36:39], s52 offen nt lds
    s_addk_i32 m0, 0x1000
    s_add_u32 s52, s52, s58
    buffer_load_dwordx4 v5, s[36:39], s52 offen nt lds
    s_addk_i32 m0, 0x1000
    v_lshl_add_u32 v6, v1, 10, v2
    v_lshrrev_b32 v1, 4, v0
    v_and_b32 v2, 15, v0
    s_lshl_b32 s43, s3, 2
    v_or_b32 v3, s43, v1
    v_xor_b32 v3, v2, v3
    v_lshlrev_b32 v3, 4, v3
    v_lshl_add_u32 v7, v1, 8, v3
    s_and_b32 s44, s31, 3
    s_lshl3_add_u32 s46, s44, s30
    s_lshl_b32 s46, s46, 20
    s_lshr_b32 s47, s31, 2
    s_lshl_b32 s48, s47, 15
    s_add_u32 s46, s46, s48
    s_lshl_b32 s45, s3, 10
    s_add_u32 s46, s46, s45
    s_add_u32 s53, s46, 786432
    s_mov_b32 s54, s53
    s_lshr_b32 s43, s3, 1
    s_lshl_b32 s43, s43, 2
    v_or_b32 v3, s43, v1
    v_lshlrev_b32 v3, 1, v3
    v_xor_b32 v3, v2, v3
    v_lshlrev_b32 v3, 4, v3
    v_lshl_add_u32 v8, v1, 8, v3
    s_lshr_b32 s44, s31, 3
    s_add_u32 s44, s44, 12
    s_and_b32 s46, s31, 7
    s_cmp_eq_u32 s46, 3
    s_cselect_b32 s44, s44, s31
    s_lshl3_add_u32 s46, s31, -93
    s_lshr_b32 s64, s31, 2
    s_cmp_eq_u32 s64, 3
    s_cselect_b32 s64, s46, s44
    s_and_b32 s44, s64, 3
    s_lshr_b32 s47, s64, 2
    s_lshl2_add_u32 s46, s30, s44
    s_lshl_b32 s46, s46, 17
    s_lshl_b32 s47, s47, 7
    s_add_u32 s46, s46, s47
    s_lshl_b32 s48, s3, 13
    s_add_u32 s55, s46, s48
    s_lshl_b32 s46, s49, 16
    s_add_u32 s47, s30, s49
    s_and_b32 s47, s47, 7
    s_lshl_b32 s47, s47, 7
    s_add_u32 s46, s46, s47
    s_add_u32 s56, s46, s48
    s_lshl_b32 s59, 1, 15
    s_lshl_b32 s44, s3, 2
    s_add_u32 s44, s44, 123904
    v_mov_b32 v12, s44
    v_and_b32 v11, 15, v0
    v_lshlrev_b32 v11, 2, v11
    v_add_u32 v11, 123904, v11
    s_mov_b32 s42, 0x200000
    s_waitcnt vmcnt(6)
    v_mov_b32 v9, 1
    s_mov_b64 exec, 1
    ds_write_b32 v12, v9 offset:48
    s_mov_b64 exec, -1
    s_mov_b32 s36, s6
    s_mov_b32 s37, s7
    s_mov_b32 s38, 0x2000000
    s_waitcnt vmcnt(2)
    v_mov_b32 v9, 1
    s_mov_b64 exec, 1
    ds_write_b32 v12, v9
    s_mov_b64 exec, -1
    buffer_load_dwordx4 v7, s[36:39], s53 offen nt lds
    s_addk_i32 m0, 0x1000
    s_addk_i32 s53, 4096
    s_and_b32 s44, s64, 3
    s_lshl2_add_u32 s44, s30, s44
    s_lshl2_add_u32 s44, s44, s3
    s_lshl_b32 s44, s44, 7
    s_add_u32 s44, s44, 851968
    s_load_dword s66, s[32:33], s44
    s_add_u32 s44, s44, 64
    s_load_dword s67, s[32:33], s44
    s_lshl2_add_u32 s44, s30, s3
    s_and_b32 s46, s31, 3
    s_lshl2_add_u32 s44, s44, s46
    s_lshr_b32 s46, s31, 2
    s_lshl3_add_u32 s44, s44, s46
    s_lshl_b32 s44, s44, 9
    s_add_u32 s44, s44, 327680
    s_add_u32 s60, s32, s44
    s_addc_u32 s61, s33, 0
    s_load_dword s76, s[60:61], 0
    s_load_dword s77, s[60:61], 64
    s_load_dword s78, s[60:61], 128
    s_load_dword s79, s[60:61], 192
    s_load_dword s76, s[60:61], 256
    s_load_dword s77, s[60:61], 320
    s_load_dword s78, s[60:61], 384
    s_load_dword s79, s[60:61], 448
    s_cmp_lg_u32 s57, 0
    s_cbranch_scc1 L_nft
    s_lshr_b32 s44, s31, 3
    s_lshl2_add_u32 s44, s30, s44
    s_lshl2_add_u32 s44, s44, s3
    s_lshl_b32 s44, s44, 8
    s_add_u32 s44, s44, 1703936
    s_add_u32 s60, s32, s44
    s_addc_u32 s61, s33, 0
    s_load_dword s68, s[60:61], 0 glc
    s_load_dword s69, s[60:61], 128 glc
    s_load_dword s70, s[60:61], 32768 glc
    s_load_dword s71, s[60:61], 32896 glc
L_nft:
    buffer_load_dwordx4 v7, s[36:39], s53 offen nt lds
    s_addk_i32 m0, 0x1000
    s_addk_i32 s53, 4096
    s_waitcnt vmcnt(2)
    v_mov_b32 v9, 2
    s_mov_b64 exec, 1
    ds_write_b32 v12, v9
    s_mov_b64 exec, -1
    buffer_load_dwordx4 v7, s[36:39], s53 offen nt lds
    s_addk_i32 m0, 0x1000
    s_addk_i32 s53, 4096
    buffer_load_dwordx4 v7, s[36:39], s53 offen nt lds
    s_addk_i32 m0, 0x1000
    s_addk_i32 s53, 4096
    buffer_load_dwordx4 v7, s[36:39], s53 offen nt lds
    s_addk_i32 m0, 0x1000
    s_addk_i32 s53, 4096
    buffer_load_dwordx4 v7, s[36:39], s53 offen nt lds
    s_addk_i32 m0, 0x1000
    s_addk_i32 s53, 4096
    s_waitcnt vmcnt(5)
    buffer_load_dwordx4 v7, s[36:39], s53 offen nt lds
    s_addk_i32 m0, 0x1000
    s_addk_i32 s53, 4096
    s_waitcnt vmcnt(5)
    buffer_load_dwordx4 v7, s[36:39], s53 offen nt lds
    s_addk_i32 m0, 0x1000
    s_mov_b32 s36, s8
    s_mov_b32 s37, s9
    s_mov_b32 s38, 0x2000000
    s_waitcnt vmcnt(3)
    v_mov_b32 v9, 3
    s_mov_b64 exec, 1
    ds_write_b32 v12, v9
    s_mov_b64 exec, -1
    s_mov_b64 exec, 0xff0
L_w1:
    ds_read_b32 v9, v11
    s_sub_u32 s42, s42, 1
    s_cbranch_scc1 L_bail
    s_waitcnt lgkmcnt(0)
    v_cmp_gt_u32 vcc, 3, v9
    s_cbranch_vccnz L_w1
    s_mov_b64 exec, -1
    buffer_load_dwordx4 v8, s[36:39], s54 offen nt lds
    s_addk_i32 m0, 0x1000
    s_addk_i32 s54, 4096
    buffer_load_dwordx4 v8, s[36:39], s54 offen nt lds
    s_addk_i32 m0, 0x1000
    s_addk_i32 s54, 4096
    buffer_load_dwordx4 v8, s[36:39], s54 offen nt lds
    s_addk_i32 m0, 0x1000
    s_addk_i32 s54, 4096
L_pad3:
    s_cbranch_execz L_mid
    buffer_load_dwordx4 v8, s[36:39], s54 offen nt lds
    s_addk_i32 m0, 0x1000
    s_addk_i32 s54, 4096
    buffer_load_dwordx4 v8, s[36:39], s54 offen nt lds
    s_addk_i32 m0, 0x1000
    s_addk_i32 s54, 4096
    s_waitcnt vmcnt(7)
    buffer_load_dwordx4 v8, s[36:39], s54 offen nt lds
    s_addk_i32 m0, 0x1000
    s_addk_i32 s54, 4096
    s_waitcnt vmcnt(7)
    buffer_load_dwordx4 v8, s[36:39], s54 offen nt lds
    s_addk_i32 m0, 0x1000
    s_addk_i32 s54, 4096
    s_waitcnt vmcnt(7)
    v_mov_b32 v9, 4
    s_mov_b64 exec, 1
    ds_write_b32 v12, v9
    s_mov_b64 exec, -1
    buffer_load_dwordx4 v8, s[36:39], s54 offen nt lds
    s_addk_i32 m0, 0x1000
    s_mov_b32 s36, s12
    s_mov_b32 s37, s13
    s_mov_b32 s38, 0x400000
    s_waitcnt vmcnt(2)
    v_mov_b32 v9, 6
    s_mov_b64 exec, 1
    ds_write_b32 v12, v9
    s_mov_b64 exec, -1
    s_waitcnt vmcnt(1)
    buffer_load_dwordx4 v6, s[36:39], s55 offen nt lds
    s_addk_i32 m0, 0x1000
    s_add_u32 s55, s55, s59
    buffer_load_dwordx4 v6, s[36:39], s55 offen nt lds
    s_addk_i32 m0, 0x1000
    s_add_u32 s55, s55, s59
    buffer_load_dwordx4 v6, s[36:39], s55 offen nt lds
    s_addk_i32 m0, 0x1000
    s_add_u32 s55, s55, s59
    buffer_load_dwordx4 v6, s[36:39], s55 offen nt lds
    s_addk_i32 m0, 0x1000
    s_waitcnt lgkmcnt(0)
    s_mov_b32 s36, s20
    s_mov_b32 s37, s21
    s_mov_b32 s38, s57
    buffer_load_dwordx4 v6, s[36:39], s56 offen nt lds
    s_addk_i32 m0, 0x1000
    s_add_u32 s56, s56, s59
    buffer_load_dwordx4 v6, s[36:39], s56 offen nt lds
    s_addk_i32 m0, 0x1000
    s_waitcnt vmcnt(6)
    v_mov_b32 v9, 7
    s_mov_b64 exec, 1
    ds_write_b32 v12, v9
    s_mov_b64 exec, -1
    s_barrier
    s_waitcnt vmcnt(0)
    v_mov_b32 v9, 8
    s_mov_b64 exec, 1
    ds_write_b32 v12, v9
    s_mov_b64 exec, -1
    s_waitcnt lgkmcnt(0)
    s_endpgm
L_cw:
    v_and_b32 v1, 15, v0
    v_lshlrev_b32 v2, 2, v1
    v_add_u32 v11, 123904, v2
    v_mov_b32 v2, 0
    ds_write_b32 v11, v2
    v_and_b32 v3, 31, v0
    v_lshlrev_b32 v3, 2, v3
    v_add_u32 v3, 123648, v3
    v_mov_b32 v4, 0x7f800000
    ds_write_b32 v3, v4
    s_sub_u32 s43, s3, 4
    s_lshr_b32 s31, s2, 3
    s_waitcnt lgkmcnt(0)
    s_barrier
    s_load_dword s45, s[32:33], 0
    s_load_dwordx8 s[20:27], s[0:1], 64
    s_and_b32 s60, s43, 3
    s_and_b32 s61, s31, 3
    s_lshr_b32 s62, s31, 2
    s_mov_b32 s34, 0x200000
    s_mov_b32 s35, 0x20000
    s_mov_b32 s42, 0x200000
    s_getreg_b32 s29, hwreg(HW_REG_XCC_ID, 0, 4)
    v_mov_b32 v10, 0xffffff00
    v_mov_b32 v19, 0
    s_lshl_b32 s44, s3, 2
    s_add_u32 s44, s44, 123904
    v_mov_b32 v12, s44
    v_lshrrev_b32 v13, 4, v0
    v_and_b32 v14, 3, v0
    s_mov_b32 s46, 0x000f000f
    s_mov_b32 s47, s46
    s_mov_b32 s41, 0x0c0c0400
    v_bfe_u32 v2, v0, 2, 2
    v_lshrrev_b32 v3, 1, v2
    v_and_b32 v4, 1, v13
    v_lshl_or_b32 v3, v4, 1, v3
    v_lshlrev_b32 v3, 1, v3
    v_lshrrev_b32 v8, 1, v14
    s_lshl_b32 s44, s60, 1
    v_or_b32 v5, s44, v8
    v_xor_b32 v3, v3, v5
    v_lshlrev_b32 v3, 4, v3
    v_and_b32 v6, 1, v0
    v_lshl_or_b32 v3, v6, 3, v3
    v_lshl_add_u32 v7, v13, 3, v2
    v_lshl_add_u32 v18, v7, 7, v3
    v_lshlrev_b32 v1, 3, v1
    v_lshl_add_u32 v74, v13, 1, v1
    v_lshlrev_b32 v13, 4, v13
    s_movk_i32 s65, 1088
    v_mad_u32_u24 v16, v14, s65, v13
    s_lshr_b32 s56, s31, 3
    s_and_b32 s57, s31, 7
    s_add_u32 s55, s31, 4
    s_lshr_b32 s55, s55, 3
    s_sub_u32 s55, s31, s55
    s_cmp_ge_u32 s43, 4
    s_cbranch_scc1 L_s1b
    s_lshl_b32 s44, s56, 8
    s_add_u32 s63, s44, 114688
    v_add_u32 v16, s63, v16
    s_mul_i32 s63, s43, 1088
    s_add_u32 s63, s63, 114688
    v_lshl_add_u32 v17, v0, 4, s63
    s_lshl_b32 s63, s30, 15
    s_add_u32 s44, s44, s63
    s_lshl_b32 s63, s57, 10
    s_add_u32 s44, s44, s63
    s_lshl_b32 s63, s60, 6
    s_add_u32 s44, s44, s63
    s_add_u32 s44, s44, 65536
    v_lshl_add_u32 v15, v14, 13, v13
    v_add_u32 v15, s44, v15
    s_lshl_b32 s44, s43, 10
    s_add_u32 s44, s44, 125056
    v_lshl_add_u32 v1, v0, 4, s44
    s_mov_b64 exec, 0xf000
L_w2:
    ds_read_b32 v9, v11
    s_sub_u32 s42, s42, 1
    s_cbranch_scc1 L_bail
    s_waitcnt lgkmcnt(0)
    v_cmp_gt_u32 vcc, 1, v9
    s_cbranch_vccnz L_w2
    s_mov_b64 exec, -1
    ds_read_b128 v[20:23], v1
    s_waitcnt lgkmcnt(0)
    v_lshlrev_b32 v24, 16, v20
    v_and_b32 v25, 0xffff0000, v20
    v_lshlrev_b32 v26, 16, v21
    v_and_b32 v27, 0xffff0000, v21
    v_lshlrev_b32 v28, 16, v22
    v_and_b32 v29, 0xffff0000, v22
    v_lshlrev_b32 v30, 16, v23
    v_and_b32 v31, 0xffff0000, v23
    v_readfirstlane_b32 s64, v24
    s_nop 1
    v_pk_add_f32 v[32:33], v[24:25], s[64:65] op_sel_hi:[1,0] neg_lo:[0,1] neg_hi:[0,1]
    v_pk_add_f32 v[34:35], v[26:27], s[64:65] op_sel_hi:[1,0] neg_lo:[0,1] neg_hi:[0,1]
    v_pk_add_f32 v[36:37], v[28:29], s[64:65] op_sel_hi:[1,0] neg_lo:[0,1] neg_hi:[0,1]
    v_pk_add_f32 v[38:39], v[30:31], s[64:65] op_sel_hi:[1,0] neg_lo:[0,1] neg_hi:[0,1]
    v_pk_mul_f32 v[4:5], v[32:33], v[32:33]
    v_pk_add_f32 v[2:3], v[32:33], v[34:35]
    v_pk_fma_f32 v[4:5], v[34:35], v[34:35], v[4:5]
    v_pk_add_f32 v[6:7], v[36:37], v[38:39]
    v_pk_fma_f32 v[4:5], v[36:37], v[36:37], v[4:5]
    v_pk_add_f32 v[2:3], v[2:3], v[6:7]
    v_pk_fma_f32 v[4:5], v[38:39], v[38:39], v[4:5]
    v_add_f32 v1, v2, v3
    v_add_f32 v3, v4, v5
    s_nop 0
    v_add_f32_dpp v1, v1, v1 row_ror:8 row_mask:0xf bank_mask:0xf
    v_add_f32_dpp v3, v3, v3 row_ror:8 row_mask:0xf bank_mask:0xf
    s_nop 0
    v_add_f32_dpp v1, v1, v1 row_ror:4 row_mask:0xf bank_mask:0xf
    v_add_f32_dpp v3, v3, v3 row_ror:4 row_mask:0xf bank_mask:0xf
    s_nop 0
    v_add_f32_dpp v1, v1, v1 row_ror:2 row_mask:0xf bank_mask:0xf
    v_add_f32_dpp v3, v3, v3 row_ror:2 row_mask:0xf bank_mask:0xf
    s_nop 0
    v_add_f32_dpp v1, v1, v1 row_ror:1 row_mask:0xf bank_mask:0xf
    v_add_f32_dpp v3, v3, v3 row_ror:1 row_mask:0xf bank_mask:0xf
    s_nop 1
    v_permlane16_swap_b32 v1, v3
    v_add_f32 v1, v1, v3
    v_mov_b32 v3, v1
    s_nop 1
    v_permlane32_swap_b32 v1, v3
    v_add_f32 v1, v1, v3
    s_nop 0
    v_readlane_b32 s66, v1, 0
    v_readlane_b32 s67, v1, 16
    v_mov_b32 v2, 0x3b000000
    s_nop 0
    v_mul_f32 v1, s66, v2
    v_mul_f32 v3, s67, v2
    v_fma_f32 v3, -v1, v1, v3
    v_add_f32 v2, s64, v1
    v_max_f32 v3, 0, v3
    v_cvt_pk_bf16_f32 v2, 0, v2
    v_cvt_pk_bf16_f32 v3, 0, v3
    v_add_f32 v3, 0x3727c5ac, v3
    v_cvt_pk_bf16_f32 v4, 0, v3
    v_sqrt_f32 v4, v4
    v_pk_add_f32 v[24:25], v[24:25], v[2:3] op_sel_hi:[1,0] neg_lo:[0,1] neg_hi:[0,1]
    v_pk_add_f32 v[26:27], v[26:27], v[2:3] op_sel_hi:[1,0] neg_lo:[0,1] neg_hi:[0,1]
    v_pk_add_f32 v[28:29], v[28:29], v[2:3] op_sel_hi:[1,0] neg_lo:[0,1] neg_hi:[0,1]
    v_pk_add_f32 v[30:31], v[30:31], v[2:3] op_sel_hi:[1,0] neg_lo:[0,1] neg_hi:[0,1]
    v_cvt_pk_bf16_f32 v4, 0, v4
L_pad0:
    s_cbranch_execz L_mid
    v_rcp_f32 v4, v4
    v_cvt_pk_bf16_f32 v24, 0, v24
    v_cvt_pk_bf16_f32 v25, 0, v25
    v_cvt_pk_bf16_f32 v26, 0, v26
    v_cvt_pk_bf16_f32 v27, 0, v27
    v_cvt_pk_bf16_f32 v28, 0, v28
    v_cvt_pk_bf16_f32 v29, 0, v29
    v_cvt_pk_bf16_f32 v30, 0, v30
    v_cvt_pk_bf16_f32 v31, 0, v31
    v_pk_mul_f32 v[24:25], v[24:25], v[4:5] op_sel_hi:[1,0]
    v_pk_mul_f32 v[26:27], v[26:27], v[4:5] op_sel_hi:[1,0]
    v_pk_mul_f32 v[28:29], v[28:29], v[4:5] op_sel_hi:[1,0]
    v_pk_mul_f32 v[30:31], v[30:31], v[4:5] op_sel_hi:[1,0]
    v_cvt_pk_bf16_f32 v20, v24, v25
    v_cvt_pk_bf16_f32 v21, v26, v27
    v_cvt_pk_bf16_f32 v22, v28, v29
    v_cvt_pk_bf16_f32 v23, v30, v31
    ds_write_b128 v17, v[20:23]
    v_mov_b32 v9, 2
    s_mov_b64 exec, 1
    ds_write_b32 v12, v9
    s_mov_b64 exec, -1
    s_waitcnt lgkmcnt(0)
    s_mul_i32 s40, s45, 1664525
    s_add_u32 s40, s40, 1013904223
    s_and_b32 s36, s40, 0xff
    s_bfe_u32 s37, s40, 0x80008
    s_bfe_u32 s38, s40, 0x80010
    s_lshr_b32 s39, s40, 24
    s_xor_b32 s48, s39, s29
    s_mov_b32 s50, s40
    s_mov_b32 s51, s40
    v_mov_b32 v70, s40
    v_mov_b32 v71, s40
    s_mov_b64 exec, 0xff
L_w3:
    ds_read_b32 v9, v11
    s_sub_u32 s42, s42, 1
    s_cbranch_scc1 L_bail
    s_waitcnt lgkmcnt(0)
    v_cmp_gt_u32 vcc, 1, v9
    s_cbranch_vccnz L_w3
    s_mov_b64 exec, -1
    ds_read_b128 v[36:39], v16 offset:0
    ds_read_b64_tr_b16 v[20:21], v18 offset:0
    ds_read_b64_tr_b16 v[22:23], v18 offset:512
    ds_read_b128 v[40:43], v16 offset:64
    ds_read_b64_tr_b16 v[24:25], v18 offset:4096
    ds_read_b64_tr_b16 v[26:27], v18 offset:4608
    ds_read_b128 v[44:47], v16 offset:128
    ds_read_b64_tr_b16 v[28:29], v18 offset:8192
    ds_read_b64_tr_b16 v[30:31], v18 offset:8704
    ds_read_b128 v[48:51], v16 offset:192
    ds_read_b64_tr_b16 v[32:33], v18 offset:12288
    ds_read_b64_tr_b16 v[34:35], v18 offset:12800
    s_waitcnt lgkmcnt(9)
    v_mfma_f32_16x16x32_bf16 v[52:55], v[20:23], v[36:39], 0
    s_waitcnt lgkmcnt(6)
    v_mfma_f32_16x16x32_bf16 v[52:55], v[24:27], v[40:43], v[52:55]
    s_waitcnt lgkmcnt(3)
    v_mfma_f32_16x16x32_bf16 v[52:55], v[28:31], v[44:47], v[52:55]
    s_waitcnt lgkmcnt(0)
    v_mfma_f32_16x16x32_bf16 v[52:55], v[32:35], v[48:51], v[52:55]
    s_mov_b64 exec, s[46:47]
    s_nop 6
    v_and_or_b32 v52, v52, v10, s36
    v_and_or_b32 v53, v53, v10, s37
    v_and_or_b32 v54, v54, v10, s38
    v_and_or_b32 v55, v55, v10, s48
    buffer_store_dwordx4 v[52:55], v15, s[32:35], 0 offen sc1
    s_branch L_qg0
L_s1b:
    s_lshl_b32 s44, s30, 7
    v_add_u32 v19, s44, v74
    s_add_u32 s44, s44, 114688
    v_add_u32 v16, s44, v16
    v_add_u32 v17, 16384, v18
    s_lshl_b32 s44, s55, 13
    s_lshl_b32 s63, s30, 8
    s_add_u32 s44, s44, s63
    s_lshl_b32 s63, s60, 6
    s_add_u32 s44, s44, s63
    s_add_u32 s44, s44, 917504
    v_lshl_add_u32 v15, v14, 11, v13
    v_add_u32 v15, s44, v15
    s_lshl_b32 s44, s55, 7
    v_add_u32 v1, s44, v74
    global_load_ushort v77, v1, s[18:19]
    s_lshl2_add_u32 s44, s30, s56
    s_lshl2_add_u32 s44, s44, s60
    s_lshl_b32 s44, s44, 8
    s_add_u32 s44, s44, 1703936
    s_add_u32 s58, s32, s44
    s_addc_u32 s59, s33, 0
    s_waitcnt lgkmcnt(0)
    s_mul_i32 s40, s45, 1664525
    s_add_u32 s40, s40, 1013904223
    s_and_b32 s36, s40, 0xff
    s_bfe_u32 s37, s40, 0x80008
    s_bfe_u32 s38, s40, 0x80010
    s_lshr_b32 s39, s40, 24
    s_xor_b32 s48, s39, s29
    s_mov_b32 s50, s40
    s_mov_b32 s51, s40
    v_mov_b32 v70, s40
    v_mov_b32 v71, s40
    s_cmp_lg_u32 s57, 3
    s_cbranch_scc1 L_s1c
    global_load_ushort v78, v19, s[22:23]
    s_lshl_b32 s44, s56, 10
    v_add_u32 v19, s44, v19
    global_load_ushort v79, v19, s[4:5]
    s_branch L_qg0
L_s1c:
    s_mov_b64 exec, 0xff
L_w4:
    ds_read_b32 v9, v11
    s_sub_u32 s42, s42, 1
    s_cbranch_scc1 L_bail
    s_waitcnt lgkmcnt(0)
    v_cmp_gt_u32 vcc, 2, v9
    s_cbranch_vccnz L_w4
    s_mov_b64 exec, -1
    ds_read_b128 v[36:39], v16 offset:0
    ds_read_b64_tr_b16 v[20:21], v17 offset:0
    ds_read_b64_tr_b16 v[22:23], v17 offset:512
    ds_read_b128 v[40:43], v16 offset:64
    ds_read_b64_tr_b16 v[24:25], v17 offset:4096
    ds_read_b64_tr_b16 v[26:27], v17 offset:4608
    s_waitcnt lgkmcnt(3)
    v_mfma_f32_16x16x32_bf16 v[52:55], v[20:23], v[36:39], 0
    s_waitcnt lgkmcnt(0)
    v_mfma_f32_16x16x32_bf16 v[52:55], v[24:27], v[40:43], v[52:55]
    s_mov_b64 exec, s[46:47]
    s_nop 6
    v_and_or_b32 v52, v52, v10, s36
    v_and_or_b32 v53, v53, v10, s37
    v_and_or_b32 v54, v54, v10, s38
    v_and_or_b32 v55, v55, v10, s39
    buffer_store_dwordx4 v[52:55], v15, s[32:35], 0 offen sc1
L_qg0:
    s_mov_b64 exec, -1
L_pad1:
    s_cbranch_execz L_mid
    v_bfe_u32 v2, v0, 2, 2
    v_bfe_u32 v4, v0, 4, 1
    v_lshl_or_b32 v3, v4, 2, v2
    v_lshlrev_b32 v3, 1, v3
    s_lshl_b32 s44, s43, 1
    v_lshrrev_b32 v5, 1, v14
    v_or_b32 v5, s44, v5
    v_xor_b32 v3, v3, v5
    v_lshlrev_b32 v3, 4, v3
    v_and_b32 v6, 1, v0
    v_lshl_or_b32 v3, v6, 3, v3
    v_lshrrev_b32 v7, 1, v13
    v_add_u32 v7, v7, v2
    v_lshl_add_u32 v3, v7, 8, v3
    v_add_u32 v75, 57344, v3
    s_movk_i32 s44, 320
    v_mad_u32_u24 v76, v14, s44, v13
    s_lshl_b32 s49, s29, 24
    s_xor_b32 s49, s49, s40
    s_lshl2_add_u32 s44, s30, s61
    s_lshl3_add_u32 s44, s44, s43
    s_lshl_b32 s44, s44, 10
    s_add_u32 s44, s44, 65536
    v_lshl_add_u32 v15, v0, 4, s44
    s_lshr_b32 s44, s43, 1
    s_mul_i32 s44, s44, 320
    s_and_b32 s63, s43, 1
    s_lshl_b32 s63, s63, 7
    s_add_u32 s44, s44, s63
    s_add_u32 s44, s44, 119040
    v_add_u32 v16, s44, v74
    s_lshl_b32 s44, s43, 12
    s_add_u32 s44, s44, 24576
    v_and_b32 v1, 15, v0
    v_lshrrev_b32 v3, 4, v13
    v_xor_b32 v3, v3, v1
    v_lshlrev_b32 v3, 4, v3
    v_lshl_add_u32 v3, v1, 8, v3
    v_add_u32 v4, s44, v3
    v_xor_b32 v5, 64, v4
    v_xor_b32 v6, 0x80, v4
    v_xor_b32 v7, 0xc0, v4
    s_lshl_b32 s44, s43, 2
    s_add_u32 s44, s44, 123648
    v_lshlrev_b32 v64, 5, v14
    v_add_u32 v65, s44, v64
    v_add_u32 v64, 123648, v64
    s_lshl_b32 s44, s43, 5
    s_add_u32 s44, s44, 120320
    s_movk_i32 s63, 320
    v_lshrrev_b32 v1, 1, v13
    v_mad_u32_u24 v66, v14, s63, v1
    v_add_u32 v66, s44, v66
    s_lshl2_add_u32 s44, s55, s60
    s_lshl_b32 s44, s44, 11
    s_add_u32 s44, s44, 917504
    v_lshl_add_u32 v17, v0, 4, s44
    s_lshl_b32 s44, s30, 16
    s_lshl_b32 s63, s61, 12
    s_add_u32 s44, s44, s63
    s_lshl_b32 s63, s62, 9
    s_add_u32 s44, s44, s63
    s_lshl_b32 s63, s43, 6
    s_add_u32 s44, s44, s63
    s_add_u32 s44, s44, 327680
    v_lshl_add_u32 v73, v14, 14, v13
    v_add_u32 v73, s44, v73
    s_lshl4_add_u32 s44, s30, s61
    s_lshl3_add_u32 s44, s44, s62
    s_lshl_b32 s44, s44, 4
    s_add_u32 s44, s44, 851968
    v_lshl_add_u32 v67, v14, 9, s44
    s_lshl_b32 s44, s43, 2
    s_add_u32 s44, s44, 124992
    v_mov_b32 v8, s44
    s_cmp_ge_u32 s43, 4
    s_cbranch_scc1 L_qg2
    s_lshr_b32 s12, s31, 3
    s_add_u32 s12, s12, 12
    s_and_b32 s13, s31, 7
    s_cmp_eq_u32 s13, 3
    s_cselect_b32 s12, s12, s31
    s_lshl3_add_u32 s13, s31, -93
    s_lshr_b32 s14, s31, 2
    s_cmp_eq_u32 s14, 3
    s_cselect_b32 s14, s13, s12
    s_and_b32 s12, s14, 3
    s_lshr_b32 s13, s14, 2
    s_lshl2_add_u32 s44, s30, s12
    s_lshl2_add_u32 s44, s44, s60
    s_lshl_b32 s63, s44, 7
    s_add_u32 s63, s63, 851968
    v_lshrrev_b32 v1, 5, v0
    v_xor_b32 v2, v0, v1
    s_lshl_b32 s54, s13, 1
    v_add_u32 v2, s54, v2
    v_and_b32 v2, 7, v2
    v_lshl_add_u32 v77, v2, 4, s63
    s_lshl_b32 s44, s44, 12
    s_add_u32 s44, s44, 327680
    v_lshl_add_u32 v78, v0, 4, s44
    s_add_u32 s68, s13, 0
    s_and_b32 s68, s68, 3
    s_lshl_b32 s68, s68, 10
    s_add_u32 s69, s13, 1
    s_and_b32 s69, s69, 3
    s_lshl_b32 s69, s69, 10
    s_add_u32 s70, s13, 2
    s_and_b32 s70, s70, 3
    s_lshl_b32 s70, s70, 10
    s_add_u32 s71, s13, 3
    s_and_b32 s71, s71, 3
    s_lshl_b32 s71, s71, 10
L_qg2:
    s_mov_b64 exec, 0xf
L_w5:
    ds_read_b32 v9, v11
    s_sub_u32 s42, s42, 1
    s_cbranch_scc1 L_bail
    s_waitcnt lgkmcnt(0)
    v_cmp_gt_u32 vcc, 3, v9
    s_cbranch_vccnz L_w5
    s_mov_b64 exec, -1
    buffer_load_dwordx4 v[52:55], v15, s[32:35], 0 offen sc1
    v_mov_b32 v9, 3
    s_mov_b64 exec, 1
    ds_write_b32 v12, v9
    s_mov_b64 exec, -1
    s_branch L_qp2
L_qp:
    buffer_load_dwordx4 v[52:55], v15, s[32:35], 0 offen sc1
    s_sub_u32 s42, s42, 1
    s_cbranch_scc1 L_bail
L_qp2:
    s_waitcnt vmcnt(0)
    v_perm_b32 v1, v53, v52, s41
    v_perm_b32 v2, v55, v54, s41
    v_permlane32_swap_b32 v52, v54
    v_permlane32_swap_b32 v53, v55
    v_lshl_or_b32 v1, v2, 16, v1
    v_add_f32 v52, v52, v54
    v_add_f32 v53, v53, v55
    v_xor_b32 v1, s49, v1
    v_and_b32 v2, 0xf0ffffff, v1
    v_permlane16_swap_b32 v52, v53
    v_cmp_ne_u32 vcc, 0, v2
    v_add_f32 v52, v52, v53
    s_cbranch_vccnz L_qp
    v_cvt_pk_bf16_f32 v52, v52, v52
    ds_write_b16 v16, v52
    v_mov_b32 v9, 4
    s_mov_b64 exec, 1
    ds_write_b32 v12, v9
    s_mov_b64 exec, -1
    v_cmp_ne_u32 vcc, 0, v1
    s_or_b32 s44, vcc_lo, vcc_hi
    v_mov_b32 v3, s44
    s_mov_b64 exec, 1
    ds_write_b32 v8, v3
    s_mov_b64 exec, -1
    v_add_u32 v16, 119040, v76
    v_and_b32 v8, 7, v0
    v_lshlrev_b32 v8, 2, v8
    v_add_u32 v8, 124992, v8
    s_mov_b32 s64, 0x3db504f3
    s_mov_b32 s66, 0x3fb8aa3b
    v_mov_b32 v72, v0
L_pad2:
    s_cbranch_execz L_mid
    s_mov_b64 exec, 0xfff
L_w6:
    ds_read_b32 v9, v11
    s_sub_u32 s42, s42, 1
    s_cbranch_scc1 L_bail
    s_waitcnt lgkmcnt(0)
    v_cmp_gt_u32 vcc, 4, v9
    s_cbranch_vccnz L_w6
    s_mov_b64 exec, -1
    ds_read_b128 v[36:39], v16 offset:0
    ds_read_b128 v[20:23], v4
    ds_read_b128 v[40:43], v16 offset:64
    ds_read_b128 v[24:27], v5
    ds_read_b128 v[44:47], v16 offset:128
    ds_read_b128 v[28:31], v6
    ds_read_b128 v[48:51], v16 offset:192
    ds_read_b128 v[32:35], v7
    s_waitcnt lgkmcnt(6)
    v_mfma_f32_16x16x32_bf16 v[52:55], v[20:23], v[36:39], 0
    s_waitcnt lgkmcnt(4)
    v_mfma_f32_16x16x32_bf16 v[52:55], v[24:27], v[40:43], v[52:55]
    s_waitcnt lgkmcnt(2)
    v_mfma_f32_16x16x32_bf16 v[52:55], v[28:31], v[44:47], v[52:55]
    s_waitcnt lgkmcnt(0)
    v_mfma_f32_16x16x32_bf16 v[52:55], v[32:35], v[48:51], v[52:55]
    v_add_u32 v16, 120320, v76
    s_nop 6
    v_cvt_pk_bf16_f32 v52, 0, v52
    v_cvt_pk_bf16_f32 v53, 0, v53
    v_cvt_pk_bf16_f32 v54, 0, v54
    v_cvt_pk_bf16_f32 v55, 0, v55
    v_pk_mul_f32 v[52:53], v[52:53], s[64:65] op_sel_hi:[1,0]
    v_pk_mul_f32 v[54:55], v[54:55], s[64:65] op_sel_hi:[1,0]
    v_cvt_pk_bf16_f32 v52, 0, v52
    v_cvt_pk_bf16_f32 v53, 0, v53
    v_cvt_pk_bf16_f32 v54, 0, v54
    v_cvt_pk_bf16_f32 v55, 0, v55
    v_max3_f32 v1, v52, v53, v54
    v_max_f32 v1, v1, v55
    v_mov_b32 v2, v1
    s_nop 1
    v_permlane16_swap_b32 v1, v2
    v_max_f32 v1, v1, v2
    v_mov_b32 v2, v1
    s_nop 1
    v_permlane32_swap_b32 v1, v2
    v_max_f32 v1, v1, v2
    v_min_f32 v1, 0x7f7fffff, v1
    s_mov_b64 exec, 15
    ds_write_b32 v65, v1
    s_mov_b64 exec, -1
L_mx:
    ds_read_b128 v[20:23], v64
    ds_read_b128 v[24:27], v64 offset:16
    s_sub_u32 s42, s42, 1
    s_cbranch_scc1 L_bail
    s_waitcnt lgkmcnt(0)
    v_max3_f32 v1, v20, v21, v22
    v_max3_f32 v2, v23, v24, v25
    v_max3_f32 v1, v1, v26, v27
    v_max_f32 v68, v1, v2
    v_cmp_eq_u32 vcc, 0x7f800000, v68
    s_cbranch_vccnz L_mx
    ds_read_b32 v9, v11
    ds_read_b32 v8, v8
    v_pk_add_f32 v[52:53], v[52:53], v[68:69] op_sel_hi:[1,0] neg_lo:[0,1] neg_hi:[0,1]
    v_pk_add_f32 v[54:55], v[54:55], v[68:69] op_sel_hi:[1,0] neg_lo:[0,1] neg_hi:[0,1]
    v_pk_mul_f32 v[52:53], v[52:53], s[66:67] op_sel_hi:[1,0]
    v_pk_mul_f32 v[54:55], v[54:55], s[66:67] op_sel_hi:[1,0]
    v_exp_f32 v52, v52
    v_exp_f32 v53, v53
    v_exp_f32 v54, v54
    v_exp_f32 v55, v55
    s_nop 0
    v_cvt_pk_bf16_f32 v2, v52, v53
    v_cvt_pk_bf16_f32 v3, v54, v55
    s_waitcnt lgkmcnt(0)
    v_cmp_ne_u32 s[26:27], 0, v8
    v_cmp_gt_u32 vcc, 7, v9
    s_mov_b64 exec, s[46:47]
    ds_write_b64 v66, v[2:3]
    v_mov_b32 v9, 6
    s_mov_b64 exec, 1
    ds_write_b32 v12, v9
    s_mov_b64 exec, -1
    s_or_b32 s28, s26, s27
    s_and_b32 s26, vcc_lo, 15
    v_add_f32 v1, v52, v53
    v_add_f32 v4, v54, v55
    v_add_f32 v1, v1, v4
    v_mov_b32 v4, v1
    s_nop 1
    v_permlane16_swap_b32 v1, v4
    v_add_f32 v1, v1, v4
    v_mov_b32 v4, v1
    s_nop 1
    v_permlane32_swap_b32 v1, v4
    v_add_f32 v1, v1, v4
    s_mov_b64 exec, 15
    ds_write_b32 v65, v1 offset:128
    s_mov_b64 exec, -1
    s_cmp_eq_u32 s26, 0
    s_cbranch_scc1 L_late
    s_mov_b64 exec, 0xfff
L_w7:
    ds_read_b32 v9, v11
    s_sub_u32 s42, s42, 1
    s_cbranch_scc1 L_bail
    s_waitcnt lgkmcnt(0)
    v_cmp_gt_u32 vcc, 6, v9
    s_cbranch_vccnz L_w7
    s_mov_b64 exec, -1
    ds_read_b128 v[36:39], v16 offset:0
    ds_read_b64_tr_b16 v[20:21], v75 offset:0
    ds_read_b64_tr_b16 v[22:23], v75 offset:1024
    ds_read_b128 v[40:43], v16 offset:64
    ds_read_b64_tr_b16 v[24:25], v75 offset:8192
    ds_read_b64_tr_b16 v[26:27], v75 offset:9216
    ds_read_b128 v[44:47], v16 offset:128
    ds_read_b64_tr_b16 v[28:29], v75 offset:16384
    ds_read_b64_tr_b16 v[30:31], v75 offset:17408
    ds_read_b128 v[48:51], v16 offset:192
    s_waitcnt lgkmcnt(7)
    v_mfma_f32_16x16x32_bf16 v[52:55], v[20:23], v[36:39], 0
    s_waitcnt lgkmcnt(4)
    v_mfma_f32_16x16x32_bf16 v[52:55], v[24:27], v[40:43], v[52:55]
    s_waitcnt lgkmcnt(1)
    v_mfma_f32_16x16x32_bf16 v[52:55], v[28:31], v[44:47], v[52:55]
L_pad4:
    s_cbranch_execz L_bail
    s_cmp_lg_u32 s43, 7
    s_barrier
    ds_read_b64_tr_b16 v[32:33], v75 offset:24576
    ds_read_b64_tr_b16 v[34:35], v75 offset:25600
    s_cbranch_scc1 L_ls1
    ds_read_b128 v[0:3], v64 offset:128
    ds_read_b128 v[4:7], v64 offset:144
L_ls1:
    s_waitcnt lgkmcnt(0)
L_pv4:
    v_mfma_f32_16x16x32_bf16 v[52:55], v[32:35], v[48:51], v[52:55]
    s_mov_b64 exec, s[46:47]
    v_pk_add_f32 v[0:1], v[0:1], v[2:3]
    v_pk_add_f32 v[4:5], v[4:5], v[6:7]
    s_cmp_lg_u32 s28, 0
    v_pk_add_f32 v[0:1], v[0:1], v[4:5]
    s_nop 1
    v_add_f32 v69, v0, v1
    v_and_or_b32 v52, v52, v10, s36
    v_and_or_b32 v53, v53, v10, s37
    v_and_or_b32 v54, v54, v10, s38
    v_and_or_b32 v55, v55, v10, s39
    s_cbranch_scc1 L_far
    buffer_store_dwordx4 v[52:55], v73, s[32:35], 0 offen
    s_cmp_lg_u32 s43, 7
    s_cbranch_scc1 L_noml3
    s_mov_b64 exec, 15
    buffer_store_dwordx4 v[68:71], v67, s[32:35], 0 offen
L_noml3:
    s_mov_b64 exec, -1
    v_mov_b32 v0, v72
    s_cmp_ge_u32 s43, 4
    s_cbranch_scc1 L_s3b
    buffer_load_dwordx4 v[44:47], v77, s[32:35], 0 offen sc1
    v_lshrrev_b32 v1, 5, v0
    s_mul_i32 s44, s43, 320
    s_add_u32 s44, s44, 121600
    v_and_b32 v2, 31, v0
    v_lshlrev_b32 v2, 3, v2
    v_lshlrev_b32 v1, 2, v1
    v_add3_u32 v17, v1, v2, s44
    s_lshl_b32 s44, s13, 16
    s_lshl3_add_u32 s63, s12, s30
    s_lshl_b32 s63, s63, 8
    s_add_u32 s44, s44, s63
    s_lshl_b32 s63, s43, 6
    s_add_u32 s44, s44, s63
    s_add_u32 s44, s44, 1179648
    v_lshl_add_u32 v19, v14, 14, v13
    v_add_u32 v19, s44, v19
    s_lshl_b32 s44, s13, 12
    s_lshl_b32 s63, s12, 7
    s_add_u32 s44, s44, s63
    s_lshl2_add_u32 s44, s30, s44
    s_add_u32 s44, s44, 1703936
    v_lshl_add_u32 v73, v14, 10, s44
    s_mov_b64 s[52:53], 15
    s_add_u32 s54, s30, s55
    s_and_b32 s54, s54, 7
    s_lshl_b32 s44, s54, 12
    s_lshr_b32 s63, s55, 3
    s_lshl_b32 s63, s63, 7
    s_add_u32 s44, s44, s63
    s_and_b32 s63, s55, 7
    s_lshl2_add_u32 s44, s63, s44
    s_add_u32 s44, s44, 1704448
    v_lshlrev_b32 v1, 2, v0
    v_and_b32 v1, 16, v1
    v_lshl_add_u32 v1, v14, 10, v1
    v_add_u32 v1, s44, v1
    v_and_b32 v2, 8, v0
    v_cmp_ne_u32 vcc, 0, v2
    s_cmp_ge_u32 s55, 24
    s_cselect_b32 s52, 0xf00f, s52
    v_cndmask_b32 v73, v73, v1, vcc
    s_bitset1_b32 s52, 8
    s_bitset1_b32 s52, 9
    s_bitset1_b32 s52, 10
    s_bitset1_b32 s52, 11
    s_cmp_eq_u32 s57, 3
    s_cselect_b32 s52, 15, s52
    s_lshl_b32 s44, s52, 16
    s_or_b32 s52, s52, s44
    v_and_b32 v1, 16, v0
    v_lshlrev_b32 v1, 11, v1
    v_add_u32 v73, v73, v1
    v_add_u32 v16, 121600, v76
    v_add_u32 v18, 90112, v18
    v_mov_b32 v76, s40
    s_branch L_oh2
L_oh:
    buffer_load_dwordx4 v[44:47], v77, s[32:35], 0 offen sc1
    s_sub_u32 s42, s42, 1
    s_cbranch_scc1 L_bail
L_oh2:
    s_waitcnt vmcnt(0)
    v_cmp_ne_u32 vcc, s40, v46
    s_cbranch_vccnz L_oh
    buffer_load_dwordx4 v[56:59], v78, s[32:35], s68 offen sc1
    buffer_load_dwordx4 v[60:63], v78, s[32:35], s69 offen sc1
    buffer_load_dwordx4 v[64:67], v78, s[32:35], s70 offen sc1
    buffer_load_dwordx4 v[68:71], v78, s[32:35], s71 offen sc1
L_oh3:
    v_max_f32_dpp v1, v44, v44 quad_perm:[1,0,3,2] row_mask:0xf bank_mask:0xf
    s_nop 1
    v_max_f32_dpp v1, v1, v1 quad_perm:[2,3,0,1] row_mask:0xf bank_mask:0xf
    s_nop 1
    v_max_f32_dpp v1, v1, v1 row_half_mirror row_mask:0xf bank_mask:0xf
    v_sub_f32 v2, v44, v1
    v_mul_f32 v2, 0x3fb8aa3b, v2
    v_exp_f32 v2, v2
    s_nop 0
    v_mul_f32 v1, v2, v45
    s_nop 1
    v_add_f32_dpp v1, v1, v1 quad_perm:[1,0,3,2] row_mask:0xf bank_mask:0xf
    s_nop 1
    v_add_f32_dpp v1, v1, v1 quad_perm:[2,3,0,1] row_mask:0xf bank_mask:0xf
    s_nop 1
    v_add_f32_dpp v1, v1, v1 row_half_mirror row_mask:0xf bank_mask:0xf
    v_rcp_f32 v1, v1
    s_nop 0
    v_mul_f32 v2, v2, v1
    s_nop 1
    v_mov_b32_dpp v36, v2 row_newbcast:0 row_mask:0xf bank_mask:0xf
    v_mov_b32_dpp v38, v2 row_newbcast:2 row_mask:0xf bank_mask:0xf
    v_mov_b32_dpp v40, v2 row_newbcast:4 row_mask:0xf bank_mask:0xf
    v_mov_b32_dpp v42, v2 row_newbcast:6 row_mask:0xf bank_mask:0xf
L_pad5:
    s_cbranch_execz L_bail
    s_mov_b64 exec, 0xf
L_w8:
    ds_read_b32 v9, v11
    s_sub_u32 s42, s42, 1
    s_cbranch_scc1 L_bail
    s_waitcnt lgkmcnt(0)
    v_cmp_gt_u32 vcc, 8, v9
    s_cbranch_vccnz L_w8
    s_mov_b64 exec, -1
    ds_read_b64_tr_b16 v[20:21], v18 offset:0
    ds_read_b64_tr_b16 v[22:23], v18 offset:512
    ds_read_b64_tr_b16 v[24:25], v18 offset:4096
    ds_read_b64_tr_b16 v[26:27], v18 offset:4608
    ds_read_b64_tr_b16 v[28:29], v18 offset:8192
    ds_read_b64_tr_b16 v[30:31], v18 offset:8704
    ds_read_b64_tr_b16 v[32:33], v18 offset:12288
    ds_read_b64_tr_b16 v[34:35], v18 offset:12800
L_op2:
    s_waitcnt vmcnt(3)
    v_pk_mul_f32 v[52:53], v[56:57], v[36:37] op_sel_hi:[1,0]
    v_pk_mul_f32 v[54:55], v[58:59], v[36:37] op_sel_hi:[1,0]
    v_perm_b32 v2, v57, v56, s41
    v_perm_b32 v3, v59, v58, s41
    s_waitcnt vmcnt(2)
    v_pk_fma_f32 v[52:53], v[60:61], v[38:39], v[52:53] op_sel_hi:[1,0,1]
    v_pk_fma_f32 v[54:55], v[62:63], v[38:39], v[54:55] op_sel_hi:[1,0,1]
    v_perm_b32 v4, v61, v60, s41
    v_perm_b32 v5, v63, v62, s41
    s_waitcnt vmcnt(1)
    v_pk_fma_f32 v[52:53], v[64:65], v[40:41], v[52:53] op_sel_hi:[1,0,1]
    v_pk_fma_f32 v[54:55], v[66:67], v[40:41], v[54:55] op_sel_hi:[1,0,1]
    v_perm_b32 v6, v65, v64, s41
    v_perm_b32 v7, v67, v66, s41
    s_waitcnt vmcnt(0)
    v_pk_fma_f32 v[52:53], v[68:69], v[42:43], v[52:53] op_sel_hi:[1,0,1]
    v_pk_fma_f32 v[54:55], v[70:71], v[42:43], v[54:55] op_sel_hi:[1,0,1]
    v_perm_b32 v8, v69, v68, s41
    v_perm_b32 v9, v71, v70, s41
    v_permlane32_swap_b32 v52, v54
    v_permlane32_swap_b32 v53, v55
    v_lshl_or_b32 v2, v3, 16, v2
    v_lshl_or_b32 v4, v5, 16, v4
    v_add_f32 v52, v52, v54
    v_add_f32 v53, v53, v55
    v_lshl_or_b32 v6, v7, 16, v6
    v_cvt_pk_bf16_f32 v52, v52, v53
    v_lshl_or_b32 v8, v9, 16, v8
    ds_write_b32 v17, v52
    v_xor_b32 v2, s40, v2
    v_xor_b32 v4, s40, v4
    v_xor_b32 v6, s40, v6
    v_xor_b32 v8, s40, v8
    v_or3_b32 v1, v2, v4, v6
    v_or_b32 v1, v1, v8
    v_cmp_ne_u32 vcc, 0, v1
    s_cbranch_vccnz L_opr
    s_cmp_lg_u32 s43, 3
    s_waitcnt lgkmcnt(0)
    s_barrier
    ds_read_b128 v[36:39], v16 offset:0
    ds_read_b128 v[40:43], v16 offset:64
    ds_read_b128 v[44:47], v16 offset:128
    ds_read_b128 v[48:51], v16 offset:192
    s_cbranch_scc1 L_e1
    s_mov_b64 exec, s[52:53]
    buffer_store_dword v76, v73, s[32:35], 0 offen sc1
    s_mov_b64 exec, -1
L_e1:
    s_waitcnt lgkmcnt(3)
    v_mfma_f32_16x16x32_bf16 v[52:55], v[20:23], v[36:39], 0
    s_waitcnt lgkmcnt(2)
    v_mfma_f32_16x16x32_bf16 v[52:55], v[24:27], v[40:43], v[52:55]
    s_waitcnt lgkmcnt(1)
    v_mfma_f32_16x16x32_bf16 v[52:55], v[28:31], v[44:47], v[52:55]
    s_waitcnt lgkmcnt(0)
    v_mfma_f32_16x16x32_bf16 v[52:55], v[32:35], v[48:51], v[52:55]
    s_mov_b64 exec, s[46:47]
    s_nop 6
    v_and_or_b32 v52, v52, v10, s36
    v_and_or_b32 v53, v53, v10, s37
    v_and_or_b32 v54, v54, v10, s38
    v_and_or_b32 v55, v55, v10, s39
    buffer_store_dwordx4 v[52:55], v19, s[32:35], 0 offen sc1
    s_endpgm
L_opr:
    v_cmp_ne_u32 vcc, 0, v2
    s_cbranch_vccz L_opr0
    buffer_load_dwordx4 v[56:59], v78, s[32:35], s68 offen sc1
L_opr0:
    v_cmp_ne_u32 vcc, 0, v4
    s_cbranch_vccz L_opr1
    buffer_load_dwordx4 v[60:63], v78, s[32:35], s69 offen sc1
L_opr1:
    v_cmp_ne_u32 vcc, 0, v6
    s_cbranch_vccz L_opr2
    buffer_load_dwordx4 v[64:67], v78, s[32:35], s70 offen sc1
L_opr2:
    v_cmp_ne_u32 vcc, 0, v8
    s_cbranch_vccz L_opr3
    buffer_load_dwordx4 v[68:71], v78, s[32:35], s71 offen sc1
L_opr3:
    s_sub_u32 s42, s42, 1
    s_cbranch_scc1 L_bail
    s_waitcnt vmcnt(0)
    s_branch L_op2
L_late:
    s_cmp_lg_u32 s43, 7
    s_waitcnt lgkmcnt(0)
    s_barrier
    s_cbranch_scc1 L_ls2
    ds_read_b128 v[0:3], v64 offset:128
    ds_read_b128 v[4:7], v64 offset:144
L_ls2:
    ds_read_b128 v[36:39], v16 offset:0
    ds_read_b64_tr_b16 v[20:21], v75 offset:0
    ds_read_b64_tr_b16 v[22:23], v75 offset:1024
    ds_read_b128 v[40:43], v16 offset:64
    ds_read_b64_tr_b16 v[24:25], v75 offset:8192
    ds_read_b64_tr_b16 v[26:27], v75 offset:9216
    ds_read_b128 v[44:47], v16 offset:128
    ds_read_b64_tr_b16 v[28:29], v75 offset:16384
    ds_read_b64_tr_b16 v[30:31], v75 offset:17408
    ds_read_b128 v[48:51], v16 offset:192
    ds_read_b64_tr_b16 v[32:33], v75 offset:24576
    ds_read_b64_tr_b16 v[34:35], v75 offset:25600
    s_waitcnt lgkmcnt(9)
    v_mfma_f32_16x16x32_bf16 v[52:55], v[20:23], v[36:39], 0
    s_waitcnt lgkmcnt(6)
    v_mfma_f32_16x16x32_bf16 v[52:55], v[24:27], v[40:43], v[52:55]
    s_waitcnt lgkmcnt(3)
    v_mfma_f32_16x16x32_bf16 v[52:55], v[28:31], v[44:47], v[52:55]
    s_waitcnt lgkmcnt(0)
    s_branch L_pv4
L_far:
    buffer_store_dwordx4 v[52:55], v73, s[32:35], 0 offen sc1
    s_cmp_lg_u32 s43, 7
    s_cbranch_scc1 L_noml3
    s_mov_b64 exec, 15
    buffer_store_dwordx4 v[68:71], v67, s[32:35], 0 offen sc1
    s_branch L_noml3
L_s3b:
    s_cmp_eq_u32 s57, 3
    s_cbranch_scc1 L_red
    buffer_load_dwordx4 v[56:59], v17, s[32:35], 0 offen sc1
    buffer_load_dwordx4 v[60:63], v17, s[32:35], 0 offen offset:1024 sc1
    s_add_u32 s54, s30, s55
    s_and_b32 s54, s54, 7
    s_lshl_b32 s44, s54, 16
    s_lshl_b32 s63, s55, 8
    s_add_u32 s44, s44, s63
    s_lshl_b32 s63, s60, 6
    s_add_u32 s44, s44, s63
    s_add_u32 s44, s44, 1187840
    v_lshl_add_u32 v15, v14, 14, v13
    v_add_u32 v15, s44, v15
    s_movk_i32 s63, 192
    v_mad_u32_u24 v16, v14, s63, v13
    v_add_u32 v16, 122880, v16
    v_add_u32 v18, 106496, v18
    s_mul_i32 s44, s60, 192
    s_add_u32 s44, s44, 122880
    v_add_u32 v64, s44, v74
    v_lshlrev_b32 v77, 16, v77
    s_waitcnt vmcnt(0)
    s_branch L_hp2
L_hp:
    buffer_load_dwordx4 v[56:59], v17, s[32:35], 0 offen sc1
    buffer_load_dwordx4 v[60:63], v17, s[32:35], 0 offen offset:1024 sc1
    s_sub_u32 s42, s42, 1
    s_cbranch_scc1 L_bail
    s_waitcnt vmcnt(0)
L_hp2:
L_pad6:
    s_cbranch_execz L_bail
    v_perm_b32 v1, v57, v56, s41
    v_perm_b32 v2, v59, v58, s41
    v_lshl_or_b32 v1, v2, 16, v1
    v_cmp_ne_u32 vcc, s40, v1
    s_cbranch_vccnz L_hp
    v_perm_b32 v1, v61, v60, s41
    v_perm_b32 v2, v63, v62, s41
    v_lshl_or_b32 v1, v2, 16, v1
    v_cmp_ne_u32 vcc, s40, v1
    s_cbranch_vccnz L_hp
    v_pk_add_f32 v[56:57], v[56:57], v[60:61]
    v_pk_add_f32 v[58:59], v[58:59], v[62:63]
    s_nop 1
    v_permlane32_swap_b32 v56, v58
    v_permlane32_swap_b32 v57, v59
    v_add_f32 v56, v56, v58
    v_add_f32 v57, v57, v59
    s_nop 1
    v_permlane16_swap_b32 v56, v57
    v_add_f32 v56, v56, v57
    v_cvt_pk_bf16_f32 v56, 0, v56
    v_add_f32 v56, v56, v77
    v_cvt_pk_bf16_f32 v56, 0, v56
    v_max_f32 v56, 0, v56
    v_mul_f32 v56, v56, v56
    v_cvt_pk_bf16_f32 v56, v56, v56
    ds_write_b16 v64, v56
    s_mov_b64 exec, 0xf
L_w9:
    ds_read_b32 v9, v11
    s_sub_u32 s42, s42, 1
    s_cbranch_scc1 L_bail
    s_waitcnt lgkmcnt(0)
    v_cmp_gt_u32 vcc, 8, v9
    s_cbranch_vccnz L_w9
    s_mov_b64 exec, -1
    ds_read_b64_tr_b16 v[20:21], v18 offset:0
    ds_read_b64_tr_b16 v[22:23], v18 offset:512
    ds_read_b64_tr_b16 v[24:25], v18 offset:4096
    ds_read_b64_tr_b16 v[26:27], v18 offset:4608
    s_cmp_lg_u32 s43, 7
    s_waitcnt lgkmcnt(0)
    s_barrier
    ds_read_b128 v[36:39], v16 offset:0
    ds_read_b128 v[40:43], v16 offset:64
    s_waitcnt lgkmcnt(1)
    v_mfma_f32_16x16x32_bf16 v[52:55], v[20:23], v[36:39], 0
    s_waitcnt lgkmcnt(0)
    v_mfma_f32_16x16x32_bf16 v[52:55], v[24:27], v[40:43], v[52:55]
    s_mov_b64 exec, s[46:47]
    s_nop 6
    v_and_or_b32 v52, v52, v10, s36
    v_and_or_b32 v53, v53, v10, s37
    v_and_or_b32 v54, v54, v10, s38
    v_and_or_b32 v55, v55, v10, s39
    buffer_store_dwordx4 v[52:55], v15, s[32:35], 0 offen sc1
    s_endpgm
L_red:
    s_lshl2_add_u32 s44, s30, s56
    s_lshl_b32 s44, s44, 14
    s_lshl_b32 s63, s60, 12
    s_add_u32 s44, s44, s63
    s_add_u32 s44, s44, 1179648
    v_lshl_add_u32 v15, v0, 4, s44
    s_lshl_b32 s44, s60, 2
    s_add_u32 s44, s44, 123968
    v_lshl_add_u32 v16, v0, 4, s44
    v_lshlrev_b32 v17, 4, v0
    v_add_u32 v17, 123968, v17
    v_lshlrev_b32 v78, 16, v78
    v_lshlrev_b32 v79, 16, v79
    s_cmp_eq_u32 s60, 3
    s_cselect_b32 s54, 2, 3
    s_cselect_b32 s52, 0, 1.0
    s_lshl_b32 s55, s54, 10
    s_barrier
L_pad7:
    s_cbranch_execz L_bail
    s_mov_b64 s[8:9], 0
    s_load_dwordx8 s[64:71], s[58:59], 0 glc
    s_load_dwordx8 s[72:79], s[58:59], 128 glc
    s_sleep 5
L_fb:
    s_load_dwordx8 s[8:15], s[58:59], 32768 glc
    s_load_dwordx8 s[16:23], s[58:59], 32896 glc
    s_waitcnt lgkmcnt(4)
    s_cmp_lg_u64 s[64:65], s[50:51]
    s_cbranch_scc1 L_fa
    s_cmp_lg_u64 s[66:67], s[50:51]
    s_cbranch_scc1 L_fa
    s_cmp_lg_u64 s[68:69], s[50:51]
    s_cbranch_scc1 L_fa
    s_cmp_lg_u64 s[70:71], s[50:51]
    s_cbranch_scc1 L_fa
    s_cmp_lg_u64 s[72:73], s[50:51]
    s_cbranch_scc1 L_fa
    s_cmp_lg_u64 s[74:75], s[50:51]
    s_cbranch_scc1 L_fa
    s_cmp_lg_u64 s[76:77], s[50:51]
    s_cbranch_scc1 L_fa
    s_cmp_lg_u64 s[78:79], s[50:51]
    s_cbranch_scc1 L_fa
    s_branch L_fok
L_fa:
    s_load_dwordx8 s[64:71], s[58:59], 0 glc
    s_load_dwordx8 s[72:79], s[58:59], 128 glc
    s_sub_u32 s42, s42, 1
    s_cbranch_scc1 L_bail
    s_waitcnt lgkmcnt(4)
    s_cmp_lg_u64 s[8:9], s[50:51]
    s_cbranch_scc1 L_fb
    s_cmp_lg_u64 s[10:11], s[50:51]
    s_cbranch_scc1 L_fb
    s_cmp_lg_u64 s[12:13], s[50:51]
    s_cbranch_scc1 L_fb
    s_cmp_lg_u64 s[14:15], s[50:51]
    s_cbranch_scc1 L_fb
    s_cmp_lg_u64 s[16:17], s[50:51]
    s_cbranch_scc1 L_fb
    s_cmp_lg_u64 s[18:19], s[50:51]
    s_cbranch_scc1 L_fb
    s_cmp_lg_u64 s[20:21], s[50:51]
    s_cbranch_scc1 L_fb
    s_cmp_lg_u64 s[22:23], s[50:51]
    s_cbranch_scc1 L_fb
L_fok:
L_fp:
    buffer_load_dwordx4 v[56:59], v15, s[32:35], 0 offen offset:0 sc1
    buffer_load_dwordx4 v[60:63], v15, s[32:35], 0 offen offset:1024 sc1
    buffer_load_dwordx4 v[64:67], v15, s[32:35], 0 offen offset:2048 sc1
    buffer_load_dwordx4 v[68:71], v15, s[32:35], s55 offen sc1
    s_sub_u32 s42, s42, 1
    s_cbranch_scc1 L_bail
L_fp2:
    s_waitcnt vmcnt(3)
    v_perm_b32 v2, v57, v56, s41
    v_perm_b32 v3, v59, v58, s41
    s_waitcnt vmcnt(2)
    v_pk_add_f32 v[52:53], v[56:57], v[60:61]
    v_pk_add_f32 v[54:55], v[58:59], v[62:63]
    v_perm_b32 v4, v61, v60, s41
    v_perm_b32 v5, v63, v62, s41
    s_waitcnt vmcnt(1)
    v_pk_add_f32 v[52:53], v[52:53], v[64:65]
    v_pk_add_f32 v[54:55], v[54:55], v[66:67]
    v_perm_b32 v6, v65, v64, s41
    v_perm_b32 v7, v67, v66, s41
    s_waitcnt vmcnt(0)
    v_pk_fma_f32 v[52:53], v[68:69], s[52:53], v[52:53] op_sel_hi:[1,0,1]
    v_pk_fma_f32 v[54:55], v[70:71], s[52:53], v[54:55] op_sel_hi:[1,0,1]
    v_perm_b32 v8, v69, v68, s41
    v_perm_b32 v9, v71, v70, s41
    v_permlane32_swap_b32 v52, v54
    v_permlane32_swap_b32 v53, v55
    v_lshl_or_b32 v2, v3, 16, v2
    v_lshl_or_b32 v4, v5, 16, v4
    v_add_f32 v52, v52, v54
    v_add_f32 v53, v53, v55
    v_lshl_or_b32 v6, v7, 16, v6
    v_lshl_or_b32 v8, v9, 16, v8
    v_permlane16_swap_b32 v52, v53
    v_xor_b32 v2, s40, v2
    v_xor_b32 v4, s40, v4
    v_add_f32 v52, v52, v53
    v_xor_b32 v6, s40, v6
    ds_write_b32 v16, v52
    v_xor_b32 v8, s40, v8
    v_or3_b32 v2, v2, v4, v6
    v_or_b32 v2, v2, v8
    v_cmp_ne_u32 vcc, 0, v2
    s_cbranch_vccnz L_fp
    s_cmp_lg_u32 s60, 0
    s_waitcnt lgkmcnt(0)
    s_barrier
    s_cbranch_scc1 L_bail
    ds_read_b128 v[56:59], v17
    s_waitcnt lgkmcnt(0)
    v_add_f32 v58, v58, v59
    v_add_f32 v56, v56, v57
    v_cvt_pk_bf16_f32 v57, 0, v58
    v_cvt_pk_bf16_f32 v56, 0, v56
    v_add_f32 v57, v57, v78
    v_cvt_pk_bf16_f32 v57, 0, v57
    v_mul_f32 v1, 0xbfb8aa3b, v57
    v_exp_f32 v1, v1
    s_nop 0
    v_add_f32 v1, 1.0, v1
    v_rcp_f32 v1, v1
    s_nop 0
    v_mul_f32 v57, v57, v1
    v_cvt_pk_bf16_f32 v57, 0, v57
    v_mul_f32 v56, v56, v57
    v_cvt_pk_bf16_f32 v56, 0, v56
    v_add_f32 v56, v56, v79
    v_cvt_pk_bf16_f32 v56, v56, v56
    global_store_short v19, v56, s[24:25] nt
    s_cmp_lg_u32 s2, 24
    s_cbranch_scc1 L_end3
    v_mov_b32 v1, 0
    v_mov_b32 v2, s40
    s_mov_b64 exec, 1
    buffer_store_dword v2, v1, s[32:35], 0 offen sc1
L_end3:
    s_endpgm
L_codeend:
.section .rodata,"a"
.p2align 6
.amdhsa_kernel recurrent_scan__sliding_block_cached__dense_activation_squared_relu__decode_kernel
  .amdhsa_next_free_vgpr 80
  .amdhsa_next_free_sgpr 102
  .amdhsa_accum_offset 80
  .amdhsa_group_segment_fixed_size 0
  .amdhsa_kernarg_size 104
  .amdhsa_user_sgpr_count 2
  .amdhsa_user_sgpr_kernarg_segment_ptr 1
  .amdhsa_system_sgpr_workgroup_id_x 1
.end_amdhsa_kernel
```
